```python
import torch

def _softmax(x, axis=-1):
    return torch.softmax(x, dim=axis)
def _gelu(x):
    return torch.nn.functional.gelu(x, approximate="tanh")
def _silu(x):
    return torch.nn.functional.silu(x)
def _sigmoid(x):
    return torch.sigmoid(x)
def _layernorm(x, axis=-1, eps=1e-5):
    m = x.mean(dim=axis, keepdim=True)
    v = x.var(dim=axis, keepdim=True, unbiased=False)
    return (x - m) / torch.sqrt(v + eps)
def _scatter_add(tgt, idx, src, axis=0):
    return tgt.clone().index_add_(axis, idx, src)
def _segment_sum(src, seg, n):
    out = torch.zeros((n,) + src.shape[1:], dtype=src.dtype)
    return out.index_add_(0, seg, src)
def _pad(x, pw):
    flat = tuple(v for pair in reversed(pw) for v in pair)
    return torch.nn.functional.pad(x, flat)

kernel_name = 'standalone__instancenorm__sampling'

def setup_inputs():

    _w = (lambda a: (lambda t: t.to(torch.bfloat16) if t.is_floating_point() else t)(torch.as_tensor(a)))
    B, C, H, W = 32, 512, 32, 32
    return {
        "x": _w(abs((lambda *s: torch.randn(*s, dtype=torch.bfloat16) * 0.05)(B, C, H, W))),
        "g": _w((lambda *s: torch.randn(*s, dtype=torch.bfloat16) * 0.05)(C) + 1.0),
        "b": _w((lambda *s: torch.randn(*s, dtype=torch.bfloat16) * 0.4)(C)),
    }

def reference(x, g, b):
    mu = x.mean(axis=(-2, -1), keepdims=True)
    var = ((x - mu) ** 2).mean(axis=(-2, -1), keepdims=True)
    xhat = (x - mu) / torch.sqrt(var + 1e-5)
    return xhat * g.reshape(1, -1, 1, 1) + b.reshape(1, -1, 1, 1)
```

```asm
; @launch grid=(256,1,1) block=(640,1,1) lds=0
.amdgcn_target "amdgcn-amd-amdhsa--gfx950"
.text
.p2align 12
.globl standalone__instancenorm__sampling_kernel
.p2align 8
.type standalone__instancenorm__sampling_kernel,@function
standalone__instancenorm__sampling_kernel:
    s_load_dwordx2 s[4:5], s[0:1], 0
    s_load_dwordx8 s[12:19], s[0:1], 8
    v_readfirstlane_b32 s3, v0
    v_and_b32 v1, 63, v0
    v_lshlrev_b32 v1, 4, v1
    s_mul_i32 s22, s2, 640
    s_add_u32 s22, s22, s3
    s_lshl_b32 s22, s22, 5
    s_lshl_b32 s6, 1, 25
    s_mov_b32 s7, 0x20000
    s_lshr_b32 s27, s22, 10
    s_and_b32 s27, s27, 0x3fc
    s_lshr_b32 s26, s3, 4
    s_or_b32 s33, s26, s2
    s_cmp_lt_u32 s33, 8
    s_cbranch_scc1 L_time
    s_waitcnt lgkmcnt(0)
    buffer_load_dwordx4 v[24:27], v1, s[4:7], s22 offen offset:0 nt
    buffer_load_dwordx4 v[28:31], v1, s[4:7], s22 offen offset:1024 nt
L_join:
    s_load_dword s30, s[12:13], s27
    s_load_dword s31, s[14:15], s27
    s_load_dwordx2 s[10:11], s[0:1], 40
    s_cmpk_ge_u32 s2, 256
    s_cbranch_scc1 L_end
    s_mov_b64 s[8:9], s[18:19]
    s_cmp_eq_u32 s22, 163840
    s_cbranch_scc1 L_init
L_inited:
    buffer_load_dword v2, v1, s[4:7], s6 offen
    buffer_load_dword v3, v1, s[4:7], s6 offen
    s_mov_b32 s18, s6
    s_mov_b32 s19, 0x20000
    s_lshl_b32 s20, -1, 16
    s_mov_b32 s21, 0x3a803a80
    v_mov_b32 v5, 0x3727c5ac
    v_mov_b32 v4, 0
    s_mov_b32 s32, 1
    s_add_u32 s23, s22, 5242880
    s_xor_b32 s23, s23, 0x2000
    s_branch L_wait
L_time:
    s_lshl1_add_u32 s26, s26, s2
    s_lshl_b32 s33, s26, 10
    s_lshl2_add_u32 s33, s3, s33
    s_add_u32 s33, s33, 0x1800000
    s_getreg_b32 s40, hwreg(HW_REG_XCC_ID, 0, 3)
    s_lshl_b32 s26, s40, 11
    s_lshl_b32 s40, s40, 28
    s_cmp_eq_u32 s22, 0
    s_cselect_b32 s40, s40, 0
    s_bitset1_b32 s40, 22
    s_movk_i32 s25, 4095
    s_waitcnt lgkmcnt(0)
    s_load_dword s41, s[4:5], s33 glc
    s_memtime s[28:29]
    buffer_load_dwordx4 v[24:27], v1, s[4:7], s22 offen offset:0 nt
    buffer_load_dwordx4 v[28:31], v1, s[4:7], s22 offen offset:1024 nt
    s_add_u32 s33, s33, s4
    s_xor_b32 s26, s26, s33
    s_lshr_b32 s33, s33, 8
    s_xor_b32 s26, s26, s33
    s_waitcnt lgkmcnt(0)
    s_memtime s[30:31]
    s_waitcnt lgkmcnt(0)
    s_sub_u32 s30, s30, s28
    s_lshr_b32 s31, s30, 2
    s_addk_i32 s31, 1536
    s_min_u32 s30, s30, s31
    s_min_u32 s30, s30, s25
    s_sub_u32 s31, s25, s30
    s_bitcmp1_b32 s26, 13
    s_cselect_b32 s30, s30, s31
    s_add_u32 s40, s40, s30
    s_atomic_add s40, s[18:19], 0
    s_branch L_join
L_wait:
    s_waitcnt vmcnt(2)
    v_dot2c_f32_bf16 v4, s21, v24
    v_dot2c_f32_bf16 v4, s21, v25
    v_dot2c_f32_bf16 v4, s21, v26
    v_dot2c_f32_bf16 v4, s21, v27
    v_dot2c_f32_bf16 v4, s21, v28
    v_dot2c_f32_bf16 v4, s21, v29
    v_dot2c_f32_bf16 v4, s21, v30
    v_dot2c_f32_bf16 v4, s21, v31
    v_lshlrev_b32 v12, 16, v24
    v_and_b32 v8, s20, v24
    v_lshlrev_b32 v13, 16, v25
    v_add_f32_dpp v4, v4, v4 row_ror:8 row_mask:0xf bank_mask:0xf
    v_and_b32 v9, s20, v25
    v_lshlrev_b32 v14, 16, v26
    v_add_f32_dpp v4, v4, v4 row_ror:4 row_mask:0xf bank_mask:0xf
    v_and_b32 v10, s20, v26
    v_lshlrev_b32 v15, 16, v27
    v_add_f32_dpp v4, v4, v4 row_ror:2 row_mask:0xf bank_mask:0xf
    v_and_b32 v11, s20, v27
    v_lshlrev_b32 v20, 16, v28
    v_add_f32_dpp v4, v4, v4 row_ror:1 row_mask:0xf bank_mask:0xf
    v_and_b32 v16, s20, v28
    v_lshlrev_b32 v21, 16, v29
    v_add_f32_dpp v4, v4, v4 row_bcast:15 row_mask:0xa bank_mask:0xf
    v_and_b32 v17, s20, v29
    v_lshlrev_b32 v22, 16, v30
    v_add_f32_dpp v4, v4, v4 row_bcast:31 row_mask:0xc bank_mask:0xf
    v_cvt_pk_bf16_f32 v4, 0, v4
    v_and_b32 v18, s20, v30
    v_readlane_b32 s28, v4, 63
    v_lshlrev_b32 v23, 16, v31
    v_and_b32 v19, s20, v31
    buffer_load_dwordx4 v[24:27], v1, s[4:7], s23 offen offset:0 nt
    buffer_load_dwordx4 v[28:31], v1, s[4:7], s23 offen offset:1024 nt
    v_pk_add_f32 v[12:13], v[12:13], s[28:29] op_sel_hi:[1,0] neg_lo:[0,1] neg_hi:[0,1]
    v_pk_mul_f32 v[6:7], v[12:13], v[12:13]
    v_pk_add_f32 v[14:15], v[14:15], s[28:29] op_sel_hi:[1,0] neg_lo:[0,1] neg_hi:[0,1]
    v_pk_fma_f32 v[6:7], v[14:15], v[14:15], v[6:7]
    v_pk_add_f32 v[8:9], v[8:9], s[28:29] op_sel_hi:[1,0] neg_lo:[0,1] neg_hi:[0,1]
    v_pk_fma_f32 v[6:7], v[8:9], v[8:9], v[6:7]
    v_pk_add_f32 v[10:11], v[10:11], s[28:29] op_sel_hi:[1,0] neg_lo:[0,1] neg_hi:[0,1]
    v_pk_fma_f32 v[6:7], v[10:11], v[10:11], v[6:7]
    v_pk_add_f32 v[20:21], v[20:21], s[28:29] op_sel_hi:[1,0] neg_lo:[0,1] neg_hi:[0,1]
    v_pk_fma_f32 v[6:7], v[20:21], v[20:21], v[6:7]
    v_pk_add_f32 v[22:23], v[22:23], s[28:29] op_sel_hi:[1,0] neg_lo:[0,1] neg_hi:[0,1]
    v_pk_fma_f32 v[6:7], v[22:23], v[22:23], v[6:7]
    v_pk_add_f32 v[16:17], v[16:17], s[28:29] op_sel_hi:[1,0] neg_lo:[0,1] neg_hi:[0,1]
    v_pk_fma_f32 v[6:7], v[16:17], v[16:17], v[6:7]
    v_pk_add_f32 v[18:19], v[18:19], s[28:29] op_sel_hi:[1,0] neg_lo:[0,1] neg_hi:[0,1]
    v_pk_fma_f32 v[6:7], v[18:19], v[18:19], v[6:7]
    v_add_f32 v6, v6, v7
    s_bitcmp1_b32 s22, 11
    s_cselect_b32 s33, 0, 16
    v_add_f32_dpp v6, v6, v6 row_ror:8 row_mask:0xf bank_mask:0xf
    s_waitcnt lgkmcnt(0)
    s_lshl_b32 s26, s30, s33
    v_add_f32_dpp v6, v6, v6 row_ror:4 row_mask:0xf bank_mask:0xf
    s_lshl_b32 s25, s31, s33
    s_and_b32 s26, s26, s20
    v_add_f32_dpp v6, v6, v6 row_ror:2 row_mask:0xf bank_mask:0xf
    s_and_b32 s25, s25, s20
    v_mov_b32 v4, 0
    v_add_f32_dpp v6, v6, v6 row_ror:1 row_mask:0xf bank_mask:0xf
    s_sub_u32 s33, s23, 20971520
    s_cmp_lt_u32 s33, 12582912
    v_add_f32_dpp v6, v6, v6 row_bcast:15 row_mask:0xa bank_mask:0xf
    s_mov_b32 s38, 1
    s_cbranch_scc0 L_noclaim
    s_atomic_add s38, s[10:11], s37 glc
L_noclaim:
    v_add_f32_dpp v6, v6, v6 row_bcast:31 row_mask:0xc bank_mask:0xf
    v_cvt_pk_bf16_f32 v6, 0, v6
    v_fmamk_f32 v6, v6, 0x3a800000, v5
    v_cvt_pk_bf16_f32 v6, 0, v6
    v_sqrt_f32 v6, v6
    s_lshr_b32 s27, s23, 10
    v_cvt_pk_bf16_f32 v6, 0, v6
    v_rcp_f32 v6, v6
    s_and_b32 s27, s27, 0x3fc
    v_mul_f32 v6, s26, v6
    s_add_u32 s32, s32, 1
    v_readlane_b32 s24, v6, 63
    s_load_dword s30, s[12:13], s27
    s_load_dword s31, s[14:15], s27
    v_pk_fma_f32 v[12:13], v[12:13], s[24:25], s[24:25] op_sel:[0,0,1] op_sel_hi:[1,0,1]
    v_pk_fma_f32 v[14:15], v[14:15], s[24:25], s[24:25] op_sel:[0,0,1] op_sel_hi:[1,0,1]
    v_pk_fma_f32 v[8:9], v[8:9], s[24:25], s[24:25] op_sel:[0,0,1] op_sel_hi:[1,0,1]
    v_pk_fma_f32 v[10:11], v[10:11], s[24:25], s[24:25] op_sel:[0,0,1] op_sel_hi:[1,0,1]
    v_cvt_pk_bf16_f32 v8, v12, v8
    v_cvt_pk_bf16_f32 v9, v13, v9
    v_cvt_pk_bf16_f32 v10, v14, v10
    v_cvt_pk_bf16_f32 v11, v15, v11
    buffer_store_dwordx4 v[8:11], v1, s[16:19], s22 offen offset:0 sc1
    v_pk_fma_f32 v[20:21], v[20:21], s[24:25], s[24:25] op_sel:[0,0,1] op_sel_hi:[1,0,1]
    v_pk_fma_f32 v[22:23], v[22:23], s[24:25], s[24:25] op_sel:[0,0,1] op_sel_hi:[1,0,1]
    v_pk_fma_f32 v[16:17], v[16:17], s[24:25], s[24:25] op_sel:[0,0,1] op_sel_hi:[1,0,1]
    v_pk_fma_f32 v[18:19], v[18:19], s[24:25], s[24:25] op_sel:[0,0,1] op_sel_hi:[1,0,1]
    v_cvt_pk_bf16_f32 v16, v20, v16
    v_cvt_pk_bf16_f32 v17, v21, v17
    v_cvt_pk_bf16_f32 v18, v22, v18
    v_cvt_pk_bf16_f32 v19, v23, v19
    buffer_store_dwordx4 v[16:19], v1, s[16:19], s22 offen offset:1024 sc1
    s_cmp_ge_u32 s23, s6
    s_cbranch_scc1 L_end
    s_mov_b32 s22, s23
    s_cmp_eq_u32 s32, 2
    s_cbranch_scc1 L_side
L_local:
    s_add_u32 s34, s34, 5242880
    s_mov_b32 s23, s34
    s_cmp_lt_u32 s32, 4
    s_cbranch_scc1 L_gotB
    s_cmp_eq_u32 s32, 4
    s_cbranch_scc1 L_ready
    s_waitcnt lgkmcnt(0)
    s_lshl_b32 s23, s38, 18
    s_add_u32 s23, s23, s36
L_gotB:
    s_add_u32 s27, s23, s4
    s_lshr_b32 s33, s27, 8
    s_xor_b32 s33, s33, s27
    s_xor_b32 s33, s33, s35
    s_and_b32 s33, s33, 0x2000
    s_or_b32 s23, s23, s33
    s_min_u32 s23, s23, s6
    s_branch L_wait
L_side:
    s_lshr_b32 s3, s3, 6
    s_and_b32 s34, s2, 3
    s_lshr_b32 s33, s2, 3
    s_lshl2_add_u32 s34, s33, s34
    s_mul_i32 s34, s34, 10
    s_add_u32 s3, s34, s3
    s_and_b32 s33, s3, 3
    s_lshr_b32 s34, s3, 2
    s_lshl3_add_u32 s34, s34, s33
    s_lshl_b32 s34, s34, 11
    s_add_u32 s34, s34, 5242880
    s_lshr_b32 s33, s3, 6
    s_mul_i32 s33, s33, 5
    s_add_u32 s37, s3, s33
    s_and_b32 s37, s37, 63
    s_and_b32 s33, s37, 3
    s_lshr_b32 s36, s37, 2
    s_lshl3_add_u32 s36, s36, s33
    s_lshl_b32 s36, s36, 11
    s_add_u32 s36, s36, 26214400
    s_lshl_b32 s37, s37, 8
    s_waitcnt vmcnt(3)
    s_load_dword s40, s[8:9], 0
    s_waitcnt lgkmcnt(0)
    s_and_b32 s33, s40, 0x84000000
    s_cbranch_scc0 L_slow
L_gotA:
    s_and_b32 s33, s40, 0x3fffff
    s_lshr_b32 s35, s40, 28
    s_cmp_le_u32 s33, 32760
    s_cselect_b32 s33, 4, 0
    s_add_u32 s35, s35, s33
    s_cmp_lt_i32 s40, 0
    s_cselect_b32 s40, 0, s35
    s_add_u32 s35, s40, s2
    s_and_b32 s35, s35, 4
    s_lshl_b32 s33, s35, 12
    s_add_u32 s37, s37, s33
    s_lshl_b32 s35, s35, 11
    s_branch L_local
L_ready:
    s_load_dword s41, s[8:9], 128
    s_waitcnt lgkmcnt(0)
    s_cmp_lg_u32 s41, 0
    s_cbranch_scc1 L_gotB
    s_mov_b32 s39, 64
    v_mov_b32 v2, 0
L_pollB:
    global_load_dword v3, v2, s[8:9] offset:128 sc1
    s_waitcnt vmcnt(0)
    v_readfirstlane_b32 s41, v3
    s_sub_u32 s39, s39, 1
    s_cmp_lg_u32 s41, 0
    s_cbranch_scc1 L_gotB
    s_cmp_lg_u32 s39, 0
    s_cbranch_scc1 L_pollB
    v_lshlrev_b32 v2, 4, v1
    v_mov_b32 v3, 0
    global_store_dword v2, v3, s[10:11] sc1
    v_add_u32 v2, 0x4000, v2
    global_store_dword v2, v3, s[10:11] sc1
    s_waitcnt vmcnt(0)
    s_mov_b32 s39, 1
    s_atomic_or s39, s[8:9], 128
    s_branch L_gotB
L_init:
    s_waitcnt lgkmcnt(0)
    v_lshlrev_b32 v2, 4, v1
    v_mov_b32 v3, 0
    global_store_dword v2, v3, s[10:11] sc1
    v_add_u32 v2, 0x4000, v2
    global_store_dword v2, v3, s[10:11] sc1
    s_waitcnt vmcnt(0)
    s_mov_b32 s39, 1
    s_atomic_or s39, s[8:9], 128
    s_branch L_inited
L_slow:
    s_mov_b32 s39, 64
    v_mov_b32 v2, 0
L_pollA:
    global_load_dword v3, v2, s[8:9] offset:0 sc1
    s_waitcnt vmcnt(0)
    v_readfirstlane_b32 s40, v3
    s_sub_u32 s39, s39, 1
    s_and_b32 s33, s40, 0x84000000
    s_cbranch_scc1 L_gotA
    s_cmp_lg_u32 s39, 0
    s_cbranch_scc1 L_pollA
L_giveup:
    s_mov_b32 s41, s40
    s_bitset1_b32 s40, 31
    s_atomic_cmpswap s[40:41], s[8:9], 0 glc
    s_waitcnt lgkmcnt(0)
    s_and_b32 s33, s40, 0x84000000
    s_cbranch_scc0 L_giveup
    s_branch L_gotA
L_end:
    s_endpgm
.section .rodata,"a"
.p2align 6
.amdhsa_kernel standalone__instancenorm__sampling_kernel
  .amdhsa_next_free_vgpr 32
  .amdhsa_next_free_sgpr 44
  .amdhsa_accum_offset 32
  .amdhsa_group_segment_fixed_size 0
  .amdhsa_kernarg_size 48
  .amdhsa_user_sgpr_count 2
  .amdhsa_user_sgpr_kernarg_segment_ptr 1
  .amdhsa_system_sgpr_workgroup_id_x 1
  .amdhsa_float_denorm_mode_32 3
.end_amdhsa_kernel
```
